```python
import torch

def _softmax(x, axis=-1):
    return torch.softmax(x, dim=axis)
def _gelu(x):
    return torch.nn.functional.gelu(x, approximate="tanh")
def _silu(x):
    return torch.nn.functional.silu(x)
def _sigmoid(x):
    return torch.sigmoid(x)
def _layernorm(x, axis=-1, eps=1e-5):
    m = x.mean(dim=axis, keepdim=True)
    v = x.var(dim=axis, keepdim=True, unbiased=False)
    return (x - m) / torch.sqrt(v + eps)
def _scatter_add(tgt, idx, src, axis=0):
    return tgt.clone().index_add_(axis, idx, src)
def _segment_sum(src, seg, n):
    out = torch.zeros((n,) + src.shape[1:], dtype=src.dtype)
    return out.index_add_(0, seg, src)
def _pad(x, pw):
    flat = tuple(v for pair in reversed(pw) for v in pair)
    return torch.nn.functional.pad(x, flat)

kernel_name = 'standalone__spectral_fnet__prompt'

def setup_inputs():

    _w = (lambda a: (lambda t: t.to(torch.bfloat16) if t.is_floating_point() else t)(torch.as_tensor(a)))
    B, S, D = 1, 2048, 448
    ns = torch.arange(S)[:, None] * torch.arange(S)[None, :]
    nd = torch.arange(D)[:, None] * torch.arange(D)[None, :]
    Ws_re = torch.cos(-2.0 * torch.pi * ns / S).to(float)
    Ws_im = torch.sin(-2.0 * torch.pi * ns / S).to(float)
    Wd_re = torch.cos(-2.0 * torch.pi * nd / D).to(float)
    Wd_im = torch.sin(-2.0 * torch.pi * nd / D).to(float)
    return {
        "x": _w((lambda *s: torch.randn(*s, dtype=torch.bfloat16) * 0.05)(B, S, D)),
        "dft_seq_re": _w(Ws_re),
        "dft_seq_im": _w(Ws_im),
        "dft_hid_re": _w(Wd_re),
        "dft_hid_im": _w(Wd_im),
    }

def reference(x, dft_seq_re, dft_seq_im, dft_hid_re, dft_hid_im):
    a = torch.einsum("bsd,ed->bse", x, dft_hid_re)
    b = torch.einsum("bsd,ed->bse", x, dft_hid_im)
    y = torch.einsum("ts,bse->bte", dft_seq_re, a) - torch.einsum("ts,bse->bte", dft_seq_im, b)
    return y
```

```asm
; @launch grid=(256,1,1) block=(384,1,1) lds=163840
.amdgcn_target "amdgcn-amd-amdhsa--gfx950"
.text
.globl standalone__spectral_fnet__prompt_kernel
.p2align 8
.type standalone__spectral_fnet__prompt_kernel,@function
standalone__spectral_fnet__prompt_kernel:
    s_cmp_ge_u32 s2, 256
    s_cbranch_scc1 L_done
    s_load_dwordx8 s[4:11], s[0:1], 0
    s_load_dwordx8 s[36:43], s[0:1], 32
    v_lshrrev_b32 v1, 6, v0
    v_and_b32 v0, 63, v0
    v_readfirstlane_b32 s17, v1
    s_lshr_b32 s13, s2, 3
    s_and_b32 s15, s13, 3
    s_and_b32 s16, s2, 1
    s_bfe_u32 s14, s2, 0x20001
    s_lshl_b32 s14, s14, 3
    s_lshr_b32 s12, s13, 2
    s_add_u32 s14, s14, s12
    s_lshl_b32 s90, s15, 2
    s_and_b32 s12, s15, 2
    s_sub_u32 s90, s90, s12
    v_lshrrev_b32 v3, 4, v0
    v_lshlrev_b32 v2, 4, v0
    s_mov_b32 s34, 0x10000000
    s_mov_b32 s35, 0x00020000
    s_cmp_lt_u32 s17, 4
    s_cbranch_scc1 L_compute
    s_sub_u32 s18, s17, 4
    v_lshrrev_b32 v20, 3, v0
    v_and_b32 v21, 7, v0
    v_lshrrev_b32 v22, 1, v20
    v_xor_b32 v23, v22, v21
    v_xor_b32 v24, 4, v23
    v_lshlrev_b32 v25, 12, v20
    v_lshl_add_u32 v23, v23, 4, v25
    v_lshl_add_u32 v24, v24, 4, v25
    v_add_u32 v4, 0, v23
    v_add_u32 v5, 31744, v24
    v_add_u32 v6, 63488, v23
    v_add_u32 v7, 95232, v24
    v_add_u32 v8, 131072, v23
    v_add_u32 v9, 162816, v24
    v_add_u32 v10, 194560, v23
    v_add_u32 v11, 226304, v24
    v_and_b32 v22, 15, v0
    v_lshlrev_b32 v23, 2, v3
    v_xor_b32 v22, v22, v23
    v_xor_b32 v24, 2, v22
    v_mul_u32_u24 v23, 896, v3
    v_lshl_add_u32 v22, v22, 4, v23
    v_lshl_add_u32 v24, v24, 4, v23
    v_add_u32 v12, 0, v22
    v_add_u32 v13, 2560, v22
    v_add_u32 v14, 5120, v24
    v_add_u32 v15, 7680, v24
    v_add_u32 v16, 14336, v22
    v_add_u32 v17, 16896, v22
    v_add_u32 v18, 19456, v24
    v_add_u32 v19, 22016, v24
    s_lshl_b32 s52, s14, 18
    s_lshl_b32 s49, s16, 11
    s_add_u32 s52, s52, s49
    s_lshl_b32 s53, s16, 10
    s_lshl_b32 s50, s18, 5
    s_add_u32 s53, s53, s50
    s_mul_i32 s53, s53, 896
    s_lshl_b32 s50, s90, 6
    s_add_u32 s53, s53, s50
    s_mov_b32 s94, s52
    s_mov_b32 s95, s53
    s_add_u32 s3, s14, s15
    s_and_b32 s3, s3, 3
    s_mov_b32 s96, 1703092544
    s_mov_b32 s97, 4275808711
    s_cmp_eq_u32 s3, 1
    s_cselect_b32 s96, 2036348193, s96
    s_cselect_b32 s97, 3488136612, s97
    s_cmp_eq_u32 s3, 2
    s_cselect_b32 s96, 2758893618, s96
    s_cselect_b32 s97, 3707365557, s97
    s_cmp_eq_u32 s3, 3
    s_cselect_b32 s96, 1699160323, s96
    s_cselect_b32 s97, 3989809547, s97
    s_lshl_b32 s50, s18, 13
    s_add_u32 s51, s50, 163840
    s_mov_b32 s26, 0x800000
    s_mov_b32 s27, 0x00020000
    s_mov_b32 s30, 1835008
    s_mov_b32 s31, 0x00020000
    s_mov_b32 s46, 401408
    s_mov_b32 s47, 0x00020000
    s_mov_b32 s3, 0
    s_cmp_eq_u32 s18, 1
    s_waitcnt lgkmcnt(0)
    s_cselect_b32 s24, s8, s6
    s_cselect_b32 s25, s9, s7
    s_mov_b32 s28, s4
    s_mov_b32 s29, s5
    s_mov_b32 s32, s42
    s_mov_b32 s33, s43
    s_mov_b32 s44, s10
    s_mov_b32 s45, s11
    s_call_b64 s[86:87], L_issue
    s_branch L_lcont
L_issue:
    s_and_b32 s49, s96, 15
    s_lshr_b64 s[96:97], s[96:97], 4
    s_lshl_b32 s52, s49, 7
    s_add_u32 s52, s52, s94
    s_mul_i32 s53, s49, 57344
    s_add_u32 s53, s53, s95
    s_add_u32 m0, s50, 0
    s_nop 0
    buffer_load_dwordx4 v4, s[24:27], s52 offen offset:0 lds
    buffer_load_dwordx4 v5, s[24:27], s52 offen offset:1024 lds
    buffer_load_dwordx4 v6, s[24:27], s52 offen offset:2048 lds
    buffer_load_dwordx4 v7, s[24:27], s52 offen offset:3072 lds
    s_add_u32 m0, s50, 4096
    s_nop 0
    buffer_load_dwordx4 v8, s[24:27], s52 offen offset:0 lds
    buffer_load_dwordx4 v9, s[24:27], s52 offen offset:1024 lds
    buffer_load_dwordx4 v10, s[24:27], s52 offen offset:2048 lds
    buffer_load_dwordx4 v11, s[24:27], s52 offen offset:3072 lds
    s_add_u32 m0, s50, 16384
    s_nop 0
    buffer_load_dwordx4 v12, s[28:31], s53 offen offset:0 lds
    buffer_load_dwordx4 v13, s[28:31], s53 offen offset:1024 lds
    buffer_load_dwordx4 v14, s[28:31], s53 offen offset:2048 lds
    buffer_load_dwordx4 v15, s[28:31], s53 offen offset:3072 lds
    s_add_u32 m0, s50, 20480
    s_nop 0
    buffer_load_dwordx4 v16, s[28:31], s53 offen offset:0 lds
    buffer_load_dwordx4 v17, s[28:31], s53 offen offset:1024 lds
    buffer_load_dwordx4 v18, s[28:31], s53 offen offset:2048 lds
    buffer_load_dwordx4 v19, s[28:31], s53 offen offset:3072 lds
    s_add_u32 s52, s52, 128
    s_add_u32 s53, s53, 57344
    s_add_u32 s50, s50, 32768
    s_sub_u32 s49, s50, 163840
    s_cmp_ge_u32 s50, s51
    s_cselect_b32 s50, s49, s50
    s_setpc_b64 s[86:87]
L_lcont:
    s_call_b64 s[86:87], L_issue
    s_lshl_b32 s12, s18, 3
    v_add_u32 v27, s12, v20
    v_add_u32 v23, 0, v27
    v_bfe_u32 v24, v23, 1, 3
    v_xor_b32 v24, v24, v21
    v_bfe_u32 v25, v23, 2, 2
    v_and_b32 v26, 3, v23
    v_lshl_add_u32 v25, v25, 3, v26
    v_add_u32 v23, 0, v25
    v_mul_u32_u24 v23, 896, v23
    v_lshl_add_u32 v32, v24, 4, v23
    v_add_u32 v23, 16, v27
    v_bfe_u32 v24, v23, 1, 3
    v_xor_b32 v24, v24, v21
    v_bfe_u32 v25, v23, 2, 2
    v_and_b32 v26, 3, v23
    v_lshl_add_u32 v25, v25, 3, v26
    v_add_u32 v23, 4, v25
    v_mul_u32_u24 v23, 896, v23
    v_lshl_add_u32 v33, v24, 4, v23
    v_add_u32 v23, 32, v27
    v_bfe_u32 v24, v23, 1, 3
    v_xor_b32 v24, v24, v21
    v_bfe_u32 v25, v23, 2, 2
    v_and_b32 v26, 3, v23
    v_lshl_add_u32 v25, v25, 3, v26
    v_add_u32 v23, 32, v25
    v_mul_u32_u24 v23, 896, v23
    v_lshl_add_u32 v34, v24, 4, v23
    v_add_u32 v23, 48, v27
    v_bfe_u32 v24, v23, 1, 3
    v_xor_b32 v24, v24, v21
    v_bfe_u32 v25, v23, 2, 2
    v_and_b32 v26, 3, v23
    v_lshl_add_u32 v25, v25, 3, v26
    v_add_u32 v23, 36, v25
    v_mul_u32_u24 v23, 896, v23
    v_lshl_add_u32 v35, v24, 4, v23
    v_add_u32 v23, 64, v27
    v_bfe_u32 v24, v23, 1, 3
    v_xor_b32 v24, v24, v21
    v_bfe_u32 v25, v23, 2, 2
    v_and_b32 v26, 3, v23
    v_lshl_add_u32 v25, v25, 3, v26
    v_add_u32 v23, 64, v25
    v_mul_u32_u24 v23, 896, v23
    v_lshl_add_u32 v36, v24, 4, v23
    v_add_u32 v23, 80, v27
    v_bfe_u32 v24, v23, 1, 3
    v_xor_b32 v24, v24, v21
    v_bfe_u32 v25, v23, 2, 2
    v_and_b32 v26, 3, v23
    v_lshl_add_u32 v25, v25, 3, v26
    v_add_u32 v23, 68, v25
    v_mul_u32_u24 v23, 896, v23
    v_lshl_add_u32 v37, v24, 4, v23
    v_add_u32 v23, 96, v27
    v_bfe_u32 v24, v23, 1, 3
    v_xor_b32 v24, v24, v21
    v_mul_u32_u24 v23, 896, v23
    v_lshl_add_u32 v38, v24, 4, v23
    s_mul_i32 s19, s15, 100352
    s_lshl_b32 s12, s18, 10
    s_mul_i32 s91, s15, 7
    s_add_u32 s91, s91, 1
    s_lshr_b32 s91, s91, 1
    s_and_b32 s98, s14, 7
    s_mul_i32 s98, s98, 7
    s_lshr_b32 s98, s98, 2
    s_add_u32 s91, s91, s98
    s_sub_u32 s98, s91, 14
    s_cmp_ge_u32 s91, 14
    s_cselect_b32 s91, s98, s91
    s_waitcnt vmcnt(16)
    s_barrier
    s_call_b64 s[86:87], L_issue
    s_call_b64 s[86:87], L_issue
    s_waitcnt vmcnt(32)
    s_barrier
    s_call_b64 s[86:87], L_issue
    s_call_b64 s[86:87], L_issue
    s_mov_b32 s3, 2
L_lloop:
    s_waitcnt vmcnt(48)
    s_barrier
    s_call_b64 s[86:87], L_issue
    s_add_u32 s3, s3, 1
    s_cmp_lt_u32 s3, 12
    s_cbranch_scc1 L_lloop
    s_waitcnt vmcnt(48)
    s_barrier
    s_add_u32 s92, s12, 32768
    s_call_b64 s[86:87], L_hissue
    s_add_u32 s92, s12, 47104
    s_call_b64 s[86:87], L_hissue
    s_waitcnt vmcnt(46)
    s_barrier
    s_add_u32 s92, s12, 61440
    s_call_b64 s[86:87], L_hissue
    s_add_u32 s92, s12, 75776
    s_call_b64 s[86:87], L_hissue
    s_waitcnt vmcnt(44)
    s_barrier
    s_add_u32 s92, s12, 90112
    s_call_b64 s[86:87], L_hissue
    s_add_u32 s92, s12, 104448
    s_call_b64 s[86:87], L_hissue
    s_waitcnt vmcnt(42)
    s_barrier
    s_add_u32 s92, s12, 118784
    s_call_b64 s[86:87], L_hissue
    s_add_u32 s92, s12, 133120
    s_call_b64 s[86:87], L_hissue
    s_add_u32 s92, s12, 147456
    s_call_b64 s[86:87], L_hissue
    s_barrier
    s_barrier
    s_add_u32 s92, s12, 0
    s_call_b64 s[86:87], L_hissue
    s_add_u32 s92, s12, 14336
    s_call_b64 s[86:87], L_hissue
    s_waitcnt vmcnt(14)
    s_barrier
    s_waitcnt vmcnt(0)
    s_barrier
    s_add_u32 s92, s12, 32768
    s_call_b64 s[86:87], L_hissue
    s_add_u32 s92, s12, 47104
    s_call_b64 s[86:87], L_hissue
    s_add_u32 s92, s12, 61440
    s_call_b64 s[86:87], L_hissue
    s_waitcnt vmcnt(0)
    s_barrier
    s_barrier
    s_barrier
    s_branch L_end
L_hissue:
    s_sub_u32 s53, s91, 7
    s_cmp_ge_u32 s91, 7
    s_cselect_b32 s52, s53, s91
    s_cselect_b32 s44, s36, s10
    s_cselect_b32 s45, s37, s11
    s_lshl_b32 s52, s52, 7
    s_add_u32 s52, s52, s19
    s_add_u32 m0, s92, 0
    s_nop 0
    buffer_load_dwordx4 v32, s[44:47], s52 offen lds
    s_add_u32 m0, s92, 2048
    s_nop 0
    buffer_load_dwordx4 v33, s[44:47], s52 offen lds
    s_add_u32 m0, s92, 4096
    s_nop 0
    buffer_load_dwordx4 v34, s[44:47], s52 offen lds
    s_add_u32 m0, s92, 6144
    s_nop 0
    buffer_load_dwordx4 v35, s[44:47], s52 offen lds
    s_add_u32 m0, s92, 8192
    s_nop 0
    buffer_load_dwordx4 v36, s[44:47], s52 offen lds
    s_add_u32 m0, s92, 10240
    s_nop 0
    buffer_load_dwordx4 v37, s[44:47], s52 offen lds
    s_add_u32 m0, s92, 12288
    s_nop 0
    buffer_load_dwordx4 v38, s[44:47], s52 offen lds
    s_add_u32 s91, s91, 1
    s_cmp_ge_u32 s91, 14
    s_cselect_b32 s91, 0, s91
    s_setpc_b64 s[86:87]
L_compute:
    s_lshr_b32 s18, s17, 1
    s_and_b32 s19, s17, 1
    s_lshl_b32 s24, s16, 1
    s_add_u32 s24, s24, s18
    s_mul_i32 s24, s24, 56
    s_add_u32 s24, s24, s90
    s_lshl_b32 s12, s19, 1
    s_add_u32 s24, s24, s12
    s_lshl_b32 s12, s14, 8
    s_add_u32 s24, s24, s12
    s_lshl_b32 s24, s24, 10
    s_add_u32 s25, s24, 1024
    s_lshl_b32 s12, s15, 1
    s_add_u32 s12, s12, s19
    s_cmp_eq_u32 s12, 4
    s_cselect_b32 s24, s25, s24
    s_cselect_b32 s31, 4, 0
    s_sub_u32 s12, s12, 3
    s_cmp_lt_u32 s12, 2
    s_cselect_b32 s25, 0x7f000000, s25
    s_cselect_b32 s89, 1, 0
    v_add_u32 v40, 0, v2
    v_add_u32 v41, 14336, v2
    v_add_u32 v42, 28672, v2
    v_add_u32 v43, 43008, v2
    v_mov_b64 v[14:15], 0
    v_mov_b32 v12, 0
    v_mov_b32 v13, 1
    s_mov_b32 s50, 256
    s_mov_b32 s51, 0x00020000
    s_mov_b32 s22, 1835008
    s_mov_b32 s23, 0x00020000
    s_lshl_b32 s52, s14, 18
    s_add_u32 s52, s52, 229376
    s_lshl_b32 s53, s16, 2
    s_add_u32 s53, s53, s15
    s_waitcnt lgkmcnt(0)
    s_mov_b32 s32, s42
    s_mov_b32 s33, s43
    s_mov_b32 s20, s38
    s_mov_b32 s21, s39
    s_mov_b32 s48, s40
    s_mov_b32 s49, s41
    s_or_b32 s12, s53, s17
    s_cmp_lg_u32 s12, 0
    s_cbranch_scc1 L_noclear
    s_mov_b64 exec, 1
    buffer_store_dwordx2 v[14:15], v12, s[32:35], s52 offen sc1
    s_waitcnt vmcnt(0)
    s_lshl_b32 s12, s14, 2
    buffer_store_dword v13, v12, s[48:51], s12 offen sc1
    s_mov_b64 exec, -1
L_noclear:
    s_add_u32 s53, s53, s52
    s_cmp_lg_u32 s17, 1
    s_cbranch_scc1 L_tw2
    s_mov_b64 exec, 1
    s_add_u32 s12, s52, 256
    buffer_load_dword v47, v12, s[32:35], s12 offen sc1
    s_mov_b64 exec, -1
L_tw2:
    s_cmp_lg_u32 s17, 2
    s_cbranch_scc1 L_tw3
    s_mov_b64 exec, 1
    s_mul_i32 s12, s14, 57344
    buffer_load_dword v46, v12, s[20:23], s12 offen sc1
    s_mov_b64 exec, -1
L_tw3:
    s_cmp_lg_u32 s17, 3
    s_cbranch_scc1 L_tw4
    s_mov_b64 exec, 1
    global_load_dword v46, v12, s[10:11]
    global_load_dword v47, v12, s[36:37]
    s_mov_b64 exec, -1
L_tw4:
    v_and_b32 v5, 15, v0
    v_lshrrev_b32 v12, 1, v5
    v_xor_b32 v12, v12, v3
    v_lshlrev_b32 v12, 4, v12
    v_lshl_add_u32 v12, v5, 7, v12
    s_lshl_b32 s12, s18, 13
    v_add_u32 v16, s12, v12
    v_xor_b32 v17, 64, v16
    v_bfe_u32 v5, v0, 2, 2
    v_lshl_add_u32 v12, v3, 3, v5
    v_lshlrev_b32 v12, 8, v12
    v_add_u32 v12, 16384, v12
    v_and_b32 v13, 3, v0
    v_lshrrev_b32 v14, 1, v13
    v_xor_b32 v14, v14, v13
    v_and_b32 v14, 1, v14
    v_lshl_add_u32 v12, v14, 3, v12
    v_and_b32 v14, 1, v3
    v_lshlrev_b32 v14, 1, v14
    v_xor_b32 v13, v13, v14
    v_lshl_add_u32 v13, v5, 2, v13
    s_lshl_b32 s12, s19, 3
    s_xor_b32 s12, s12, s31
    v_xor_b32 v13, s12, v13
    v_xor_b32 v14, 0, v13
    v_lshl_add_u32 v18, v14, 4, v12
    v_xor_b32 v20, 8, v18
    v_xor_b32 v14, 4, v13
    v_lshl_add_u32 v19, v14, 4, v12
    v_xor_b32 v21, 8, v19
    v_mov_b32 v22, v16
    v_mov_b32 v23, v17
    v_mov_b32 v24, v18
    v_mov_b32 v25, v19
    v_mov_b32 v26, v20
    v_mov_b32 v27, v21
    v_mov_b64 v[48:49], 0
    v_mov_b64 v[50:51], 0
    v_mov_b64 v[52:53], 0
    v_mov_b64 v[54:55], 0
    v_mov_b64 v[56:57], 0
    v_mov_b64 v[58:59], 0
    v_mov_b64 v[60:61], 0
    v_mov_b64 v[62:63], 0
    v_mov_b64 v[64:65], 0
    v_mov_b64 v[66:67], 0
    v_mov_b64 v[68:69], 0
    v_mov_b64 v[70:71], 0
    v_mov_b64 v[72:73], 0
    v_mov_b64 v[74:75], 0
    v_mov_b64 v[76:77], 0
    v_mov_b64 v[78:79], 0
    v_mov_b64 v[80:81], 0
    v_mov_b64 v[82:83], 0
    v_mov_b64 v[84:85], 0
    v_mov_b64 v[86:87], 0
    v_mov_b64 v[88:89], 0
    v_mov_b64 v[90:91], 0
    v_mov_b64 v[92:93], 0
    v_mov_b64 v[94:95], 0
    v_mov_b64 v[96:97], 0
    v_mov_b64 v[98:99], 0
    v_mov_b64 v[100:101], 0
    v_mov_b64 v[102:103], 0
    v_mov_b64 v[104:105], 0
    v_mov_b64 v[106:107], 0
    v_mov_b64 v[108:109], 0
    v_mov_b64 v[110:111], 0
    v_mov_b32 v12, 0
    v_mov_b32 v13, 1
    s_mov_b32 vcc_lo, 0xffff0000
    s_mov_b32 vcc_hi, 0x0000ffff
    s_cmp_eq_u32 s18, 1
    s_cselect_b32 s12, 0x80008000, 0
    s_mov_b32 s28, 0
    s_mov_b32 s29, 0
    s_barrier
    s_cmp_eq_u32 s89, 1
    s_cbranch_scc0 L_full
    ds_read_b64_tr_b16 v[112:113], v24 offset:0
    ds_read_b64_tr_b16 v[114:115], v24 offset:1024
    ds_read_b128 v[128:131], v22 offset:0
    ds_read_b128 v[132:135], v22 offset:2048
    ds_read_b128 v[136:139], v22 offset:4096
    ds_read_b128 v[140:143], v22 offset:6144
    ds_read_b64_tr_b16 v[116:117], v26 offset:0
    ds_read_b64_tr_b16 v[118:119], v26 offset:1024
L_mainh:
    s_waitcnt lgkmcnt(5)
    v_mfma_f32_16x16x32_bf16 v[48:51], v[112:115], v[128:131], v[48:51]
    ds_read_b64_tr_b16 v[144:145], v24 offset:8192
    ds_read_b64_tr_b16 v[146:147], v24 offset:9216
    s_waitcnt lgkmcnt(6)
    v_mfma_f32_16x16x32_bf16 v[52:55], v[112:115], v[132:135], v[52:55]
    ds_read_b128 v[160:163], v23 offset:0
    ds_read_b128 v[164:167], v23 offset:2048
    s_waitcnt lgkmcnt(7)
    v_mfma_f32_16x16x32_bf16 v[56:59], v[112:115], v[136:139], v[56:59]
    ds_read_b128 v[168:171], v23 offset:4096
    ds_read_b128 v[172:175], v23 offset:6144
    s_waitcnt lgkmcnt(8)
    v_mfma_f32_16x16x32_bf16 v[60:63], v[112:115], v[140:143], v[60:63]
    ds_read_b64_tr_b16 v[148:149], v26 offset:8192
    ds_read_b64_tr_b16 v[150:151], v26 offset:9216
    s_waitcnt lgkmcnt(8)
    v_mfma_f32_16x16x32_bf16 v[64:67], v[116:119], v[128:131], v[64:67]
    v_mfma_f32_16x16x32_bf16 v[68:71], v[116:119], v[132:135], v[68:71]
    v_mfma_f32_16x16x32_bf16 v[72:75], v[116:119], v[136:139], v[72:75]
    v_mfma_f32_16x16x32_bf16 v[76:79], v[116:119], v[140:143], v[76:79]
    s_waitcnt lgkmcnt(5)
    v_mfma_f32_16x16x32_bf16 v[48:51], v[144:147], v[160:163], v[48:51]
    s_add_u32 s29, s29, 32768
    s_cmp_ge_u32 s29, 163840
    s_cselect_b32 s29, 0, s29
    v_add_u32 v22, s29, v16
    v_add_u32 v23, s29, v17
    s_waitcnt lgkmcnt(4)
    v_mfma_f32_16x16x32_bf16 v[52:55], v[144:147], v[164:167], v[52:55]
    v_add_u32 v24, s29, v18
    v_add_u32 v25, s29, v19
    s_waitcnt lgkmcnt(3)
    v_mfma_f32_16x16x32_bf16 v[56:59], v[144:147], v[168:171], v[56:59]
    v_add_u32 v26, s29, v20
    v_add_u32 v27, s29, v21
    s_waitcnt lgkmcnt(2)
    v_mfma_f32_16x16x32_bf16 v[60:63], v[144:147], v[172:175], v[60:63]
    s_waitcnt lgkmcnt(0)
    s_barrier
    ds_read_b64_tr_b16 v[112:113], v24 offset:0
    ds_read_b64_tr_b16 v[114:115], v24 offset:1024
    v_mfma_f32_16x16x32_bf16 v[64:67], v[148:151], v[160:163], v[64:67]
    ds_read_b128 v[128:131], v22 offset:0
    ds_read_b128 v[132:135], v22 offset:2048
    v_mfma_f32_16x16x32_bf16 v[68:71], v[148:151], v[164:167], v[68:71]
    ds_read_b128 v[136:139], v22 offset:4096
    ds_read_b128 v[140:143], v22 offset:6144
    v_mfma_f32_16x16x32_bf16 v[72:75], v[148:151], v[168:171], v[72:75]
    ds_read_b64_tr_b16 v[116:117], v26 offset:0
    ds_read_b64_tr_b16 v[118:119], v26 offset:1024
    v_mfma_f32_16x16x32_bf16 v[76:79], v[148:151], v[172:175], v[76:79]
    s_add_u32 s28, s28, 1
    s_cmp_lt_u32 s28, 16
    s_cbranch_scc1 L_mainh
    s_branch L_mdone
L_full:
    ds_read_b64_tr_b16 v[112:113], v24 offset:0
    ds_read_b64_tr_b16 v[114:115], v24 offset:1024
    ds_read_b128 v[128:131], v22 offset:0
    ds_read_b128 v[132:135], v22 offset:2048
    ds_read_b128 v[136:139], v22 offset:4096
    ds_read_b128 v[140:143], v22 offset:6144
    ds_read_b64_tr_b16 v[116:117], v26 offset:0
    ds_read_b64_tr_b16 v[118:119], v26 offset:1024
    ds_read_b64_tr_b16 v[120:121], v25 offset:0
    ds_read_b64_tr_b16 v[122:123], v25 offset:1024
    ds_read_b64_tr_b16 v[124:125], v27 offset:0
    ds_read_b64_tr_b16 v[126:127], v27 offset:1024
L_main:
    s_waitcnt lgkmcnt(9)
    v_mfma_f32_16x16x32_bf16 v[48:51], v[112:115], v[128:131], v[48:51]
    ds_read_b64_tr_b16 v[144:145], v24 offset:8192
    s_waitcnt lgkmcnt(9)
    v_mfma_f32_16x16x32_bf16 v[52:55], v[112:115], v[132:135], v[52:55]
    ds_read_b64_tr_b16 v[146:147], v24 offset:9216
    s_waitcnt lgkmcnt(9)
    v_mfma_f32_16x16x32_bf16 v[56:59], v[112:115], v[136:139], v[56:59]
    ds_read_b128 v[160:163], v23 offset:0
    s_waitcnt lgkmcnt(9)
    v_mfma_f32_16x16x32_bf16 v[60:63], v[112:115], v[140:143], v[60:63]
    ds_read_b128 v[164:167], v23 offset:2048
    s_waitcnt lgkmcnt(8)
    v_mfma_f32_16x16x32_bf16 v[64:67], v[116:119], v[128:131], v[64:67]
    ds_read_b128 v[168:171], v23 offset:4096
    v_mfma_f32_16x16x32_bf16 v[68:71], v[116:119], v[132:135], v[68:71]
    ds_read_b128 v[172:175], v23 offset:6144
    v_mfma_f32_16x16x32_bf16 v[72:75], v[116:119], v[136:139], v[72:75]
    ds_read_b64_tr_b16 v[148:149], v26 offset:8192
    v_mfma_f32_16x16x32_bf16 v[76:79], v[116:119], v[140:143], v[76:79]
    ds_read_b64_tr_b16 v[150:151], v26 offset:9216
    s_waitcnt lgkmcnt(10)
    v_mfma_f32_16x16x32_bf16 v[80:83], v[120:123], v[128:131], v[80:83]
    ds_read_b64_tr_b16 v[152:153], v25 offset:8192
    v_mfma_f32_16x16x32_bf16 v[84:87], v[120:123], v[132:135], v[84:87]
    ds_read_b64_tr_b16 v[154:155], v25 offset:9216
    v_mfma_f32_16x16x32_bf16 v[88:91], v[120:123], v[136:139], v[88:91]
    ds_read_b64_tr_b16 v[156:157], v27 offset:8192
    v_mfma_f32_16x16x32_bf16 v[92:95], v[120:123], v[140:143], v[92:95]
    ds_read_b64_tr_b16 v[158:159], v27 offset:9216
    s_waitcnt lgkmcnt(12)
    v_mfma_f32_16x16x32_bf16 v[96:99], v[124:127], v[128:131], v[96:99]
    v_mfma_f32_16x16x32_bf16 v[100:103], v[124:127], v[132:135], v[100:103]
    v_mfma_f32_16x16x32_bf16 v[104:107], v[124:127], v[136:139], v[104:107]
    v_mfma_f32_16x16x32_bf16 v[108:111], v[124:127], v[140:143], v[108:111]
    s_waitcnt lgkmcnt(9)
    v_mfma_f32_16x16x32_bf16 v[48:51], v[144:147], v[160:163], v[48:51]
    s_add_u32 s29, s29, 32768
    s_cmp_ge_u32 s29, 163840
    s_cselect_b32 s29, 0, s29
    v_add_u32 v22, s29, v16
    v_add_u32 v23, s29, v17
    s_waitcnt lgkmcnt(8)
    v_mfma_f32_16x16x32_bf16 v[52:55], v[144:147], v[164:167], v[52:55]
    v_add_u32 v24, s29, v18
    v_add_u32 v25, s29, v19
    s_waitcnt lgkmcnt(7)
    v_mfma_f32_16x16x32_bf16 v[56:59], v[144:147], v[168:171], v[56:59]
    v_add_u32 v26, s29, v20
    v_add_u32 v27, s29, v21
    s_waitcnt lgkmcnt(6)
    v_mfma_f32_16x16x32_bf16 v[60:63], v[144:147], v[172:175], v[60:63]
    s_waitcnt lgkmcnt(0)
    s_barrier
    ds_read_b64_tr_b16 v[112:113], v24 offset:0
    ds_read_b64_tr_b16 v[114:115], v24 offset:1024
    v_mfma_f32_16x16x32_bf16 v[64:67], v[148:151], v[160:163], v[64:67]
    ds_read_b128 v[128:131], v22 offset:0
    ds_read_b128 v[132:135], v22 offset:2048
    v_mfma_f32_16x16x32_bf16 v[68:71], v[148:151], v[164:167], v[68:71]
    ds_read_b128 v[136:139], v22 offset:4096
    v_mfma_f32_16x16x32_bf16 v[72:75], v[148:151], v[168:171], v[72:75]
    ds_read_b128 v[140:143], v22 offset:6144
    v_mfma_f32_16x16x32_bf16 v[76:79], v[148:151], v[172:175], v[76:79]
    ds_read_b64_tr_b16 v[116:117], v26 offset:0
    v_mfma_f32_16x16x32_bf16 v[80:83], v[152:155], v[160:163], v[80:83]
    ds_read_b64_tr_b16 v[118:119], v26 offset:1024
    v_mfma_f32_16x16x32_bf16 v[84:87], v[152:155], v[164:167], v[84:87]
    ds_read_b64_tr_b16 v[120:121], v25 offset:0
    v_mfma_f32_16x16x32_bf16 v[88:91], v[152:155], v[168:171], v[88:91]
    ds_read_b64_tr_b16 v[122:123], v25 offset:1024
    v_mfma_f32_16x16x32_bf16 v[92:95], v[152:155], v[172:175], v[92:95]
    ds_read_b64_tr_b16 v[124:125], v27 offset:0
    v_mfma_f32_16x16x32_bf16 v[96:99], v[156:159], v[160:163], v[96:99]
    ds_read_b64_tr_b16 v[126:127], v27 offset:1024
    v_mfma_f32_16x16x32_bf16 v[100:103], v[156:159], v[164:167], v[100:103]
    v_mfma_f32_16x16x32_bf16 v[104:107], v[156:159], v[168:171], v[104:107]
    v_mfma_f32_16x16x32_bf16 v[108:111], v[156:159], v[172:175], v[108:111]
    s_add_u32 s28, s28, 1
    s_cmp_lt_u32 s28, 16
    s_cbranch_scc1 L_main
L_mdone:
    s_lshl_b32 s3, s14, 2
    s_load_dword s30, s[40:41], s3
    s_nop 2
    v_cvt_pk_bf16_f32 v192, v48, v49
    v_cvt_pk_bf16_f32 v193, v50, v51
    v_cvt_pk_bf16_f32 v194, v64, v65
    v_cvt_pk_bf16_f32 v195, v66, v67
    v_xor_b32 v192, s12, v192
    v_xor_b32 v193, s12, v193
    v_xor_b32 v194, s12, v194
    v_xor_b32 v195, s12, v195
    v_cndmask_b32 v196, v192, v194, vcc
    v_cndmask_b32 v197, v193, v195, vcc
    v_cndmask_b32 v198, v194, v192, vcc
    v_cndmask_b32 v199, v195, v193, vcc
    buffer_store_dwordx4 v[196:199], v40, s[32:35], s24 offen sc1
    v_cvt_pk_bf16_f32 v200, v80, v81
    v_cvt_pk_bf16_f32 v201, v82, v83
    v_cvt_pk_bf16_f32 v202, v96, v97
    v_cvt_pk_bf16_f32 v203, v98, v99
    v_xor_b32 v200, s12, v200
    v_xor_b32 v201, s12, v201
    v_xor_b32 v202, s12, v202
    v_xor_b32 v203, s12, v203
    v_cndmask_b32 v204, v200, v202, vcc
    v_cndmask_b32 v205, v201, v203, vcc
    v_cndmask_b32 v206, v202, v200, vcc
    v_cndmask_b32 v207, v203, v201, vcc
    buffer_store_dwordx4 v[204:207], v40, s[32:35], s25 offen sc1
    v_cvt_pk_bf16_f32 v208, v52, v53
    v_cvt_pk_bf16_f32 v209, v54, v55
    v_cvt_pk_bf16_f32 v210, v68, v69
    v_cvt_pk_bf16_f32 v211, v70, v71
    v_xor_b32 v208, s12, v208
    v_xor_b32 v209, s12, v209
    v_xor_b32 v210, s12, v210
    v_xor_b32 v211, s12, v211
    v_cndmask_b32 v212, v208, v210, vcc
    v_cndmask_b32 v213, v209, v211, vcc
    v_cndmask_b32 v214, v210, v208, vcc
    v_cndmask_b32 v215, v211, v209, vcc
    buffer_store_dwordx4 v[212:215], v41, s[32:35], s24 offen sc1
    v_cvt_pk_bf16_f32 v216, v84, v85
    v_cvt_pk_bf16_f32 v217, v86, v87
    v_cvt_pk_bf16_f32 v218, v100, v101
    v_cvt_pk_bf16_f32 v219, v102, v103
    v_xor_b32 v216, s12, v216
    v_xor_b32 v217, s12, v217
    v_xor_b32 v218, s12, v218
    v_xor_b32 v219, s12, v219
    v_cndmask_b32 v220, v216, v218, vcc
    v_cndmask_b32 v221, v217, v219, vcc
    v_cndmask_b32 v222, v218, v216, vcc
    v_cndmask_b32 v223, v219, v217, vcc
    buffer_store_dwordx4 v[220:223], v41, s[32:35], s25 offen sc1
    v_cvt_pk_bf16_f32 v224, v56, v57
    v_cvt_pk_bf16_f32 v225, v58, v59
    v_cvt_pk_bf16_f32 v226, v72, v73
    v_cvt_pk_bf16_f32 v227, v74, v75
    v_xor_b32 v224, s12, v224
    v_xor_b32 v225, s12, v225
    v_xor_b32 v226, s12, v226
    v_xor_b32 v227, s12, v227
    v_cndmask_b32 v228, v224, v226, vcc
    v_cndmask_b32 v229, v225, v227, vcc
    v_cndmask_b32 v230, v226, v224, vcc
    v_cndmask_b32 v231, v227, v225, vcc
    buffer_store_dwordx4 v[228:231], v42, s[32:35], s24 offen sc1
    v_cvt_pk_bf16_f32 v232, v88, v89
    v_cvt_pk_bf16_f32 v233, v90, v91
    v_cvt_pk_bf16_f32 v234, v104, v105
    v_cvt_pk_bf16_f32 v235, v106, v107
    v_xor_b32 v232, s12, v232
    v_xor_b32 v233, s12, v233
    v_xor_b32 v234, s12, v234
    v_xor_b32 v235, s12, v235
    v_cndmask_b32 v236, v232, v234, vcc
    v_cndmask_b32 v237, v233, v235, vcc
    v_cndmask_b32 v238, v234, v232, vcc
    v_cndmask_b32 v239, v235, v233, vcc
    buffer_store_dwordx4 v[236:239], v42, s[32:35], s25 offen sc1
    v_cvt_pk_bf16_f32 v240, v60, v61
    v_cvt_pk_bf16_f32 v241, v62, v63
    v_cvt_pk_bf16_f32 v242, v76, v77
    v_cvt_pk_bf16_f32 v243, v78, v79
    v_xor_b32 v240, s12, v240
    v_xor_b32 v241, s12, v241
    v_xor_b32 v242, s12, v242
    v_xor_b32 v243, s12, v243
    v_cndmask_b32 v244, v240, v242, vcc
    v_cndmask_b32 v245, v241, v243, vcc
    v_cndmask_b32 v246, v242, v240, vcc
    v_cndmask_b32 v247, v243, v241, vcc
    buffer_store_dwordx4 v[244:247], v43, s[32:35], s24 offen sc1
    v_cvt_pk_bf16_f32 v248, v92, v93
    v_cvt_pk_bf16_f32 v249, v94, v95
    v_cvt_pk_bf16_f32 v250, v108, v109
    v_cvt_pk_bf16_f32 v251, v110, v111
    v_xor_b32 v248, s12, v248
    v_xor_b32 v249, s12, v249
    v_xor_b32 v250, s12, v250
    v_xor_b32 v251, s12, v251
    v_cndmask_b32 v252, v248, v250, vcc
    v_cndmask_b32 v253, v249, v251, vcc
    v_cndmask_b32 v254, v250, v248, vcc
    v_cndmask_b32 v255, v251, v249, vcc
    buffer_store_dwordx4 v[252:255], v43, s[32:35], s25 offen sc1
    s_waitcnt lgkmcnt(0)
    v_and_b32 v4, 15, v0
    v_lshrrev_b32 v5, 1, v4
    s_lshl_b32 s24, s19, 2
    v_add_u32 v6, s24, v3
    v_xor_b32 v5, v5, v6
    v_lshlrev_b32 v5, 4, v5
    v_lshl_add_u32 v5, v4, 7, v5
    s_lshl_b32 s24, s14, 18
    s_mul_i32 s25, s16, 28672
    s_add_u32 s24, s24, s25
    s_lshl_b32 s25, s19, 10
    s_add_u32 s24, s24, s25
    s_mul_i32 s26, s15, 7
    s_add_u32 s26, s26, 1
    s_lshr_b32 s26, s26, 1
    s_and_b32 s98, s14, 7
    s_mul_i32 s98, s98, 7
    s_lshr_b32 s98, s98, 2
    s_add_u32 s26, s26, s98
    s_sub_u32 s98, s26, 14
    s_cmp_ge_u32 s26, 14
    s_cselect_b32 s26, s98, s26
    s_add_u32 s26, s26, s18
    s_add_u32 s25, s26, 0
    s_sub_u32 s27, s25, 14
    s_cmp_ge_u32 s25, 14
    s_cselect_b32 s25, s27, s25
    s_sub_u32 s27, s25, 7
    s_cmp_ge_u32 s25, 7
    s_cselect_b32 s25, s27, s25
    s_cselect_b32 s27, 57344, 0
    s_lshl_b32 s25, s25, 11
    s_add_u32 s25, s25, s27
    s_add_u32 s91, s25, s24
    s_add_u32 s25, s26, 2
    s_sub_u32 s27, s25, 14
    s_cmp_ge_u32 s25, 14
    s_cselect_b32 s25, s27, s25
    s_sub_u32 s27, s25, 7
    s_cmp_ge_u32 s25, 7
    s_cselect_b32 s25, s27, s25
    s_cselect_b32 s27, 57344, 0
    s_lshl_b32 s25, s25, 11
    s_add_u32 s25, s25, s27
    s_add_u32 s92, s25, s24
    s_add_u32 s25, s26, 4
    s_sub_u32 s27, s25, 14
    s_cmp_ge_u32 s25, 14
    s_cselect_b32 s25, s27, s25
    s_sub_u32 s27, s25, 7
    s_cmp_ge_u32 s25, 7
    s_cselect_b32 s25, s27, s25
    s_cselect_b32 s27, 57344, 0
    s_lshl_b32 s25, s25, 11
    s_add_u32 s25, s25, s27
    s_add_u32 s93, s25, s24
    s_add_u32 s25, s26, 6
    s_sub_u32 s27, s25, 14
    s_cmp_ge_u32 s25, 14
    s_cselect_b32 s25, s27, s25
    s_sub_u32 s27, s25, 7
    s_cmp_ge_u32 s25, 7
    s_cselect_b32 s25, s27, s25
    s_cselect_b32 s27, 57344, 0
    s_lshl_b32 s25, s25, 11
    s_add_u32 s25, s25, s27
    s_add_u32 s94, s25, s24
    s_add_u32 s25, s26, 8
    s_sub_u32 s27, s25, 14
    s_cmp_ge_u32 s25, 14
    s_cselect_b32 s25, s27, s25
    s_sub_u32 s27, s25, 7
    s_cmp_ge_u32 s25, 7
    s_cselect_b32 s25, s27, s25
    s_cselect_b32 s27, 57344, 0
    s_lshl_b32 s25, s25, 11
    s_add_u32 s25, s25, s27
    s_add_u32 s95, s25, s24
    s_add_u32 s25, s26, 10
    s_sub_u32 s27, s25, 14
    s_cmp_ge_u32 s25, 14
    s_cselect_b32 s25, s27, s25
    s_sub_u32 s27, s25, 7
    s_cmp_ge_u32 s25, 7
    s_cselect_b32 s25, s27, s25
    s_cselect_b32 s27, 57344, 0
    s_lshl_b32 s25, s25, 11
    s_add_u32 s25, s25, s27
    s_add_u32 s96, s25, s24
    s_add_u32 s25, s26, 12
    s_sub_u32 s27, s25, 14
    s_cmp_ge_u32 s25, 14
    s_cselect_b32 s25, s27, s25
    s_sub_u32 s27, s25, 7
    s_cmp_ge_u32 s25, 7
    s_cselect_b32 s25, s27, s25
    s_cselect_b32 s27, 57344, 0
    s_lshl_b32 s25, s25, 11
    s_add_u32 s25, s25, s27
    s_add_u32 s97, s25, s24
    v_mov_b32 v24, v2
    v_add_u32 v25, 14336, v2
    v_add_u32 v26, 114688, v2
    v_add_u32 v27, 129024, v2
    s_cmp_eq_u32 s18, 1
    s_mov_b32 s24, 32768
    s_cselect_b32 s24, 47104, s24
    v_add_u32 v16, s24, v5
    s_mov_b32 s24, 61440
    s_cselect_b32 s24, 75776, s24
    v_add_u32 v17, s24, v5
    s_mov_b32 s24, 90112
    s_cselect_b32 s24, 104448, s24
    v_add_u32 v18, s24, v5
    s_mov_b32 s24, 118784
    s_cselect_b32 s24, 133120, s24
    v_add_u32 v19, s24, v5
    s_mov_b32 s24, 147456
    s_cselect_b32 s24, 0, s24
    v_add_u32 v20, s24, v5
    s_mov_b32 s24, 14336
    s_cselect_b32 s24, 32768, s24
    v_add_u32 v21, s24, v5
    s_mov_b32 s24, 47104
    s_cselect_b32 s24, 61440, s24
    v_add_u32 v22, s24, v5
    v_mov_b64 v[32:33], 0
    v_mov_b64 v[34:35], 0
    v_mov_b64 v[36:37], 0
    v_mov_b64 v[38:39], 0
    v_mov_b64 v[40:41], 0
    v_mov_b64 v[42:43], 0
    v_mov_b64 v[44:45], 0
    v_mov_b64 v[46:47], 0
    v_mov_b64 v[48:49], 0
    v_mov_b64 v[50:51], 0
    v_mov_b64 v[52:53], 0
    v_mov_b64 v[54:55], 0
    v_mov_b64 v[56:57], 0
    v_mov_b64 v[58:59], 0
    v_mov_b64 v[60:61], 0
    v_mov_b64 v[62:63], 0
    v_mov_b64 v[64:65], 0
    v_mov_b64 v[66:67], 0
    v_mov_b64 v[68:69], 0
    v_mov_b64 v[70:71], 0
    v_mov_b64 v[72:73], 0
    v_mov_b64 v[74:75], 0
    v_mov_b64 v[76:77], 0
    v_mov_b64 v[78:79], 0
    v_mov_b64 v[80:81], 0
    v_mov_b64 v[82:83], 0
    v_mov_b64 v[84:85], 0
    v_mov_b64 v[86:87], 0
    s_waitcnt vmcnt(0)
    s_barrier
    s_cmp_lg_u32 s17, 0
    s_cbranch_scc1 L_nopoll
    s_mov_b64 exec, 1
    s_cmp_eq_u32 s30, 1
    s_cbranch_scc0 L_clrslow
L_clrok:
    buffer_store_byte v13, v12, s[32:35], s53 offen sc1
    s_mov_b32 s28, 0
L_poll:
    buffer_load_dwordx2 v[14:15], v12, s[32:35], s52 offen sc1
    s_add_u32 s28, s28, 1
    s_waitcnt vmcnt(0)
    v_and_b32 v14, v14, v15
    s_nop 0
    v_readfirstlane_b32 s12, v14
    s_cmp_eq_u32 s12, 0x01010101
    s_cbranch_scc1 L_pollx
    s_sleep 4
    s_cmp_lt_u32 s28, 0x400000
    s_cbranch_scc1 L_poll
L_pollx:
    s_mov_b64 exec, -1
L_nopoll:
    s_barrier
    buffer_load_dwordx4 v[88:91], v24, s[32:35], s91 offen sc1
    buffer_load_dwordx4 v[92:95], v25, s[32:35], s91 offen sc1
    buffer_load_dwordx4 v[96:99], v26, s[32:35], s91 offen sc1
    buffer_load_dwordx4 v[100:103], v27, s[32:35], s91 offen sc1
    buffer_load_dwordx4 v[104:107], v24, s[32:35], s92 offen sc1
    buffer_load_dwordx4 v[108:111], v25, s[32:35], s92 offen sc1
    buffer_load_dwordx4 v[112:115], v26, s[32:35], s92 offen sc1
    buffer_load_dwordx4 v[116:119], v27, s[32:35], s92 offen sc1
    ds_read_b128 v[200:203], v16 offset:0
    ds_read_b128 v[204:207], v16 offset:2048
    ds_read_b128 v[208:211], v16 offset:4096
    ds_read_b128 v[212:215], v16 offset:6144
    ds_read_b128 v[216:219], v16 offset:8192
    ds_read_b128 v[220:223], v16 offset:10240
    ds_read_b128 v[224:227], v16 offset:12288
    s_waitcnt vmcnt(4)
    buffer_load_dwordx4 v[120:123], v24, s[32:35], s93 offen sc1
    buffer_load_dwordx4 v[124:127], v25, s[32:35], s93 offen sc1
    buffer_load_dwordx4 v[128:131], v26, s[32:35], s93 offen sc1
    buffer_load_dwordx4 v[132:135], v27, s[32:35], s93 offen sc1
    s_waitcnt lgkmcnt(6)
    v_mfma_f32_16x16x32_bf16 v[32:35], v[200:203], v[88:91], v[32:35]
    v_mfma_f32_16x16x32_bf16 v[36:39], v[200:203], v[92:95], v[36:39]
    v_mfma_f32_16x16x32_bf16 v[32:35], v[200:203], v[96:99], v[32:35]
    ds_read_b128 v[228:231], v17 offset:0
    v_mfma_f32_16x16x32_bf16 v[36:39], v[200:203], v[100:103], v[36:39]
    s_waitcnt lgkmcnt(6)
    v_mfma_f32_16x16x32_bf16 v[40:43], v[204:207], v[88:91], v[40:43]
    v_mfma_f32_16x16x32_bf16 v[44:47], v[204:207], v[92:95], v[44:47]
    v_mfma_f32_16x16x32_bf16 v[40:43], v[204:207], v[96:99], v[40:43]
    ds_read_b128 v[232:235], v17 offset:2048
    v_mfma_f32_16x16x32_bf16 v[44:47], v[204:207], v[100:103], v[44:47]
    s_waitcnt lgkmcnt(6)
    v_mfma_f32_16x16x32_bf16 v[48:51], v[208:211], v[88:91], v[48:51]
    v_mfma_f32_16x16x32_bf16 v[52:55], v[208:211], v[92:95], v[52:55]
    v_mfma_f32_16x16x32_bf16 v[48:51], v[208:211], v[96:99], v[48:51]
    ds_read_b128 v[236:239], v17 offset:4096
    v_mfma_f32_16x16x32_bf16 v[52:55], v[208:211], v[100:103], v[52:55]
    s_waitcnt lgkmcnt(6)
    v_mfma_f32_16x16x32_bf16 v[56:59], v[212:215], v[88:91], v[56:59]
    v_mfma_f32_16x16x32_bf16 v[60:63], v[212:215], v[92:95], v[60:63]
    v_mfma_f32_16x16x32_bf16 v[56:59], v[212:215], v[96:99], v[56:59]
    ds_read_b128 v[240:243], v17 offset:6144
    v_mfma_f32_16x16x32_bf16 v[60:63], v[212:215], v[100:103], v[60:63]
    s_waitcnt lgkmcnt(6)
    v_mfma_f32_16x16x32_bf16 v[64:67], v[216:219], v[88:91], v[64:67]
    v_mfma_f32_16x16x32_bf16 v[68:71], v[216:219], v[92:95], v[68:71]
    v_mfma_f32_16x16x32_bf16 v[64:67], v[216:219], v[96:99], v[64:67]
    ds_read_b128 v[244:247], v17 offset:8192
    v_mfma_f32_16x16x32_bf16 v[68:71], v[216:219], v[100:103], v[68:71]
    s_waitcnt lgkmcnt(6)
    v_mfma_f32_16x16x32_bf16 v[72:75], v[220:223], v[88:91], v[72:75]
    v_mfma_f32_16x16x32_bf16 v[76:79], v[220:223], v[92:95], v[76:79]
    v_mfma_f32_16x16x32_bf16 v[72:75], v[220:223], v[96:99], v[72:75]
    ds_read_b128 v[248:251], v17 offset:10240
    v_mfma_f32_16x16x32_bf16 v[76:79], v[220:223], v[100:103], v[76:79]
    s_waitcnt lgkmcnt(6)
    v_mfma_f32_16x16x32_bf16 v[80:83], v[224:227], v[88:91], v[80:83]
    v_mfma_f32_16x16x32_bf16 v[84:87], v[224:227], v[92:95], v[84:87]
    v_mfma_f32_16x16x32_bf16 v[80:83], v[224:227], v[96:99], v[80:83]
    ds_read_b128 v[252:255], v17 offset:12288
    v_mfma_f32_16x16x32_bf16 v[84:87], v[224:227], v[100:103], v[84:87]
    s_waitcnt lgkmcnt(0)
    s_barrier
    s_waitcnt vmcnt(4)
    buffer_load_dwordx4 v[136:139], v24, s[32:35], s94 offen sc1
    buffer_load_dwordx4 v[140:143], v25, s[32:35], s94 offen sc1
    buffer_load_dwordx4 v[144:147], v26, s[32:35], s94 offen sc1
    buffer_load_dwordx4 v[148:151], v27, s[32:35], s94 offen sc1
    v_mfma_f32_16x16x32_bf16 v[32:35], v[228:231], v[104:107], v[32:35]
    v_mfma_f32_16x16x32_bf16 v[36:39], v[228:231], v[108:111], v[36:39]
    v_mfma_f32_16x16x32_bf16 v[32:35], v[228:231], v[112:115], v[32:35]
    ds_read_b128 v[200:203], v18 offset:0
    v_mfma_f32_16x16x32_bf16 v[36:39], v[228:231], v[116:119], v[36:39]
    v_mfma_f32_16x16x32_bf16 v[40:43], v[232:235], v[104:107], v[40:43]
    v_mfma_f32_16x16x32_bf16 v[44:47], v[232:235], v[108:111], v[44:47]
    v_mfma_f32_16x16x32_bf16 v[40:43], v[232:235], v[112:115], v[40:43]
    ds_read_b128 v[204:207], v18 offset:2048
    v_mfma_f32_16x16x32_bf16 v[44:47], v[232:235], v[116:119], v[44:47]
    v_mfma_f32_16x16x32_bf16 v[48:51], v[236:239], v[104:107], v[48:51]
    v_mfma_f32_16x16x32_bf16 v[52:55], v[236:239], v[108:111], v[52:55]
    v_mfma_f32_16x16x32_bf16 v[48:51], v[236:239], v[112:115], v[48:51]
    ds_read_b128 v[208:211], v18 offset:4096
    v_mfma_f32_16x16x32_bf16 v[52:55], v[236:239], v[116:119], v[52:55]
    v_mfma_f32_16x16x32_bf16 v[56:59], v[240:243], v[104:107], v[56:59]
    v_mfma_f32_16x16x32_bf16 v[60:63], v[240:243], v[108:111], v[60:63]
    v_mfma_f32_16x16x32_bf16 v[56:59], v[240:243], v[112:115], v[56:59]
    ds_read_b128 v[212:215], v18 offset:6144
    v_mfma_f32_16x16x32_bf16 v[60:63], v[240:243], v[116:119], v[60:63]
    v_mfma_f32_16x16x32_bf16 v[64:67], v[244:247], v[104:107], v[64:67]
    v_mfma_f32_16x16x32_bf16 v[68:71], v[244:247], v[108:111], v[68:71]
    v_mfma_f32_16x16x32_bf16 v[64:67], v[244:247], v[112:115], v[64:67]
    ds_read_b128 v[216:219], v18 offset:8192
    v_mfma_f32_16x16x32_bf16 v[68:71], v[244:247], v[116:119], v[68:71]
    v_mfma_f32_16x16x32_bf16 v[72:75], v[248:251], v[104:107], v[72:75]
    v_mfma_f32_16x16x32_bf16 v[76:79], v[248:251], v[108:111], v[76:79]
    v_mfma_f32_16x16x32_bf16 v[72:75], v[248:251], v[112:115], v[72:75]
    ds_read_b128 v[220:223], v18 offset:10240
    v_mfma_f32_16x16x32_bf16 v[76:79], v[248:251], v[116:119], v[76:79]
    v_mfma_f32_16x16x32_bf16 v[80:83], v[252:255], v[104:107], v[80:83]
    v_mfma_f32_16x16x32_bf16 v[84:87], v[252:255], v[108:111], v[84:87]
    v_mfma_f32_16x16x32_bf16 v[80:83], v[252:255], v[112:115], v[80:83]
    ds_read_b128 v[224:227], v18 offset:12288
    v_mfma_f32_16x16x32_bf16 v[84:87], v[252:255], v[116:119], v[84:87]
    s_waitcnt vmcnt(4)
    buffer_load_dwordx4 v[152:155], v24, s[32:35], s95 offen sc1
    buffer_load_dwordx4 v[156:159], v25, s[32:35], s95 offen sc1
    buffer_load_dwordx4 v[160:163], v26, s[32:35], s95 offen sc1
    buffer_load_dwordx4 v[164:167], v27, s[32:35], s95 offen sc1
    s_waitcnt lgkmcnt(6)
    v_mfma_f32_16x16x32_bf16 v[32:35], v[200:203], v[120:123], v[32:35]
    v_mfma_f32_16x16x32_bf16 v[36:39], v[200:203], v[124:127], v[36:39]
    v_mfma_f32_16x16x32_bf16 v[32:35], v[200:203], v[128:131], v[32:35]
    ds_read_b128 v[228:231], v19 offset:0
    v_mfma_f32_16x16x32_bf16 v[36:39], v[200:203], v[132:135], v[36:39]
    s_waitcnt lgkmcnt(6)
    v_mfma_f32_16x16x32_bf16 v[40:43], v[204:207], v[120:123], v[40:43]
    v_mfma_f32_16x16x32_bf16 v[44:47], v[204:207], v[124:127], v[44:47]
    v_mfma_f32_16x16x32_bf16 v[40:43], v[204:207], v[128:131], v[40:43]
    ds_read_b128 v[232:235], v19 offset:2048
    v_mfma_f32_16x16x32_bf16 v[44:47], v[204:207], v[132:135], v[44:47]
    s_waitcnt lgkmcnt(6)
    v_mfma_f32_16x16x32_bf16 v[48:51], v[208:211], v[120:123], v[48:51]
    v_mfma_f32_16x16x32_bf16 v[52:55], v[208:211], v[124:127], v[52:55]
    v_mfma_f32_16x16x32_bf16 v[48:51], v[208:211], v[128:131], v[48:51]
    ds_read_b128 v[236:239], v19 offset:4096
    v_mfma_f32_16x16x32_bf16 v[52:55], v[208:211], v[132:135], v[52:55]
    s_waitcnt lgkmcnt(6)
    v_mfma_f32_16x16x32_bf16 v[56:59], v[212:215], v[120:123], v[56:59]
    v_mfma_f32_16x16x32_bf16 v[60:63], v[212:215], v[124:127], v[60:63]
    v_mfma_f32_16x16x32_bf16 v[56:59], v[212:215], v[128:131], v[56:59]
    ds_read_b128 v[240:243], v19 offset:6144
    v_mfma_f32_16x16x32_bf16 v[60:63], v[212:215], v[132:135], v[60:63]
    s_waitcnt lgkmcnt(6)
    v_mfma_f32_16x16x32_bf16 v[64:67], v[216:219], v[120:123], v[64:67]
    v_mfma_f32_16x16x32_bf16 v[68:71], v[216:219], v[124:127], v[68:71]
    v_mfma_f32_16x16x32_bf16 v[64:67], v[216:219], v[128:131], v[64:67]
    ds_read_b128 v[244:247], v19 offset:8192
    v_mfma_f32_16x16x32_bf16 v[68:71], v[216:219], v[132:135], v[68:71]
    s_waitcnt lgkmcnt(6)
    v_mfma_f32_16x16x32_bf16 v[72:75], v[220:223], v[120:123], v[72:75]
    v_mfma_f32_16x16x32_bf16 v[76:79], v[220:223], v[124:127], v[76:79]
    v_mfma_f32_16x16x32_bf16 v[72:75], v[220:223], v[128:131], v[72:75]
    ds_read_b128 v[248:251], v19 offset:10240
    v_mfma_f32_16x16x32_bf16 v[76:79], v[220:223], v[132:135], v[76:79]
    s_waitcnt lgkmcnt(6)
    v_mfma_f32_16x16x32_bf16 v[80:83], v[224:227], v[120:123], v[80:83]
    v_mfma_f32_16x16x32_bf16 v[84:87], v[224:227], v[124:127], v[84:87]
    v_mfma_f32_16x16x32_bf16 v[80:83], v[224:227], v[128:131], v[80:83]
    ds_read_b128 v[252:255], v19 offset:12288
    v_mfma_f32_16x16x32_bf16 v[84:87], v[224:227], v[132:135], v[84:87]
    s_waitcnt vmcnt(4)
    buffer_load_dwordx4 v[168:171], v24, s[32:35], s96 offen sc1
    buffer_load_dwordx4 v[172:175], v25, s[32:35], s96 offen sc1
    buffer_load_dwordx4 v[176:179], v26, s[32:35], s96 offen sc1
    buffer_load_dwordx4 v[180:183], v27, s[32:35], s96 offen sc1
    s_waitcnt lgkmcnt(6)
    v_mfma_f32_16x16x32_bf16 v[32:35], v[228:231], v[136:139], v[32:35]
    v_mfma_f32_16x16x32_bf16 v[36:39], v[228:231], v[140:143], v[36:39]
    v_mfma_f32_16x16x32_bf16 v[32:35], v[228:231], v[144:147], v[32:35]
    ds_read_b128 v[200:203], v20 offset:0
    v_mfma_f32_16x16x32_bf16 v[36:39], v[228:231], v[148:151], v[36:39]
    s_waitcnt lgkmcnt(6)
    v_mfma_f32_16x16x32_bf16 v[40:43], v[232:235], v[136:139], v[40:43]
    v_mfma_f32_16x16x32_bf16 v[44:47], v[232:235], v[140:143], v[44:47]
    v_mfma_f32_16x16x32_bf16 v[40:43], v[232:235], v[144:147], v[40:43]
    ds_read_b128 v[204:207], v20 offset:2048
    v_mfma_f32_16x16x32_bf16 v[44:47], v[232:235], v[148:151], v[44:47]
    s_waitcnt lgkmcnt(6)
    v_mfma_f32_16x16x32_bf16 v[48:51], v[236:239], v[136:139], v[48:51]
    v_mfma_f32_16x16x32_bf16 v[52:55], v[236:239], v[140:143], v[52:55]
    v_mfma_f32_16x16x32_bf16 v[48:51], v[236:239], v[144:147], v[48:51]
    ds_read_b128 v[208:211], v20 offset:4096
    v_mfma_f32_16x16x32_bf16 v[52:55], v[236:239], v[148:151], v[52:55]
    s_waitcnt lgkmcnt(6)
    v_mfma_f32_16x16x32_bf16 v[56:59], v[240:243], v[136:139], v[56:59]
    v_mfma_f32_16x16x32_bf16 v[60:63], v[240:243], v[140:143], v[60:63]
    v_mfma_f32_16x16x32_bf16 v[56:59], v[240:243], v[144:147], v[56:59]
    ds_read_b128 v[212:215], v20 offset:6144
    v_mfma_f32_16x16x32_bf16 v[60:63], v[240:243], v[148:151], v[60:63]
    s_waitcnt lgkmcnt(6)
    v_mfma_f32_16x16x32_bf16 v[64:67], v[244:247], v[136:139], v[64:67]
    v_mfma_f32_16x16x32_bf16 v[68:71], v[244:247], v[140:143], v[68:71]
    v_mfma_f32_16x16x32_bf16 v[64:67], v[244:247], v[144:147], v[64:67]
    ds_read_b128 v[216:219], v20 offset:8192
    v_mfma_f32_16x16x32_bf16 v[68:71], v[244:247], v[148:151], v[68:71]
    s_waitcnt lgkmcnt(6)
    v_mfma_f32_16x16x32_bf16 v[72:75], v[248:251], v[136:139], v[72:75]
    v_mfma_f32_16x16x32_bf16 v[76:79], v[248:251], v[140:143], v[76:79]
    v_mfma_f32_16x16x32_bf16 v[72:75], v[248:251], v[144:147], v[72:75]
    ds_read_b128 v[220:223], v20 offset:10240
    v_mfma_f32_16x16x32_bf16 v[76:79], v[248:251], v[148:151], v[76:79]
    s_waitcnt lgkmcnt(6)
    v_mfma_f32_16x16x32_bf16 v[80:83], v[252:255], v[136:139], v[80:83]
    v_mfma_f32_16x16x32_bf16 v[84:87], v[252:255], v[140:143], v[84:87]
    v_mfma_f32_16x16x32_bf16 v[80:83], v[252:255], v[144:147], v[80:83]
    ds_read_b128 v[224:227], v20 offset:12288
    v_mfma_f32_16x16x32_bf16 v[84:87], v[252:255], v[148:151], v[84:87]
    s_barrier
    s_waitcnt vmcnt(4)
    buffer_load_dwordx4 v[184:187], v24, s[32:35], s97 offen sc1
    buffer_load_dwordx4 v[188:191], v25, s[32:35], s97 offen sc1
    buffer_load_dwordx4 v[192:195], v26, s[32:35], s97 offen sc1
    buffer_load_dwordx4 v[196:199], v27, s[32:35], s97 offen sc1
    s_waitcnt lgkmcnt(6)
    v_mfma_f32_16x16x32_bf16 v[32:35], v[200:203], v[152:155], v[32:35]
    v_mfma_f32_16x16x32_bf16 v[36:39], v[200:203], v[156:159], v[36:39]
    v_mfma_f32_16x16x32_bf16 v[32:35], v[200:203], v[160:163], v[32:35]
    ds_read_b128 v[228:231], v21 offset:0
    v_mfma_f32_16x16x32_bf16 v[36:39], v[200:203], v[164:167], v[36:39]
    s_waitcnt lgkmcnt(6)
    v_mfma_f32_16x16x32_bf16 v[40:43], v[204:207], v[152:155], v[40:43]
    v_mfma_f32_16x16x32_bf16 v[44:47], v[204:207], v[156:159], v[44:47]
    v_mfma_f32_16x16x32_bf16 v[40:43], v[204:207], v[160:163], v[40:43]
    ds_read_b128 v[232:235], v21 offset:2048
    v_mfma_f32_16x16x32_bf16 v[44:47], v[204:207], v[164:167], v[44:47]
    s_waitcnt lgkmcnt(6)
    v_mfma_f32_16x16x32_bf16 v[48:51], v[208:211], v[152:155], v[48:51]
    v_mfma_f32_16x16x32_bf16 v[52:55], v[208:211], v[156:159], v[52:55]
    v_mfma_f32_16x16x32_bf16 v[48:51], v[208:211], v[160:163], v[48:51]
    ds_read_b128 v[236:239], v21 offset:4096
    v_mfma_f32_16x16x32_bf16 v[52:55], v[208:211], v[164:167], v[52:55]
    s_waitcnt lgkmcnt(6)
    v_mfma_f32_16x16x32_bf16 v[56:59], v[212:215], v[152:155], v[56:59]
    v_mfma_f32_16x16x32_bf16 v[60:63], v[212:215], v[156:159], v[60:63]
    v_mfma_f32_16x16x32_bf16 v[56:59], v[212:215], v[160:163], v[56:59]
    ds_read_b128 v[240:243], v21 offset:6144
    v_mfma_f32_16x16x32_bf16 v[60:63], v[212:215], v[164:167], v[60:63]
    s_waitcnt lgkmcnt(6)
    v_mfma_f32_16x16x32_bf16 v[64:67], v[216:219], v[152:155], v[64:67]
    v_mfma_f32_16x16x32_bf16 v[68:71], v[216:219], v[156:159], v[68:71]
    v_mfma_f32_16x16x32_bf16 v[64:67], v[216:219], v[160:163], v[64:67]
    ds_read_b128 v[244:247], v21 offset:8192
    v_mfma_f32_16x16x32_bf16 v[68:71], v[216:219], v[164:167], v[68:71]
    s_waitcnt lgkmcnt(6)
    v_mfma_f32_16x16x32_bf16 v[72:75], v[220:223], v[152:155], v[72:75]
    v_mfma_f32_16x16x32_bf16 v[76:79], v[220:223], v[156:159], v[76:79]
    v_mfma_f32_16x16x32_bf16 v[72:75], v[220:223], v[160:163], v[72:75]
    ds_read_b128 v[248:251], v21 offset:10240
    v_mfma_f32_16x16x32_bf16 v[76:79], v[220:223], v[164:167], v[76:79]
    s_waitcnt lgkmcnt(6)
    v_mfma_f32_16x16x32_bf16 v[80:83], v[224:227], v[152:155], v[80:83]
    v_mfma_f32_16x16x32_bf16 v[84:87], v[224:227], v[156:159], v[84:87]
    v_mfma_f32_16x16x32_bf16 v[80:83], v[224:227], v[160:163], v[80:83]
    ds_read_b128 v[252:255], v21 offset:12288
    v_mfma_f32_16x16x32_bf16 v[84:87], v[224:227], v[164:167], v[84:87]
    s_waitcnt vmcnt(4)
    s_waitcnt lgkmcnt(6)
    v_mfma_f32_16x16x32_bf16 v[32:35], v[228:231], v[168:171], v[32:35]
    v_mfma_f32_16x16x32_bf16 v[36:39], v[228:231], v[172:175], v[36:39]
    v_mfma_f32_16x16x32_bf16 v[32:35], v[228:231], v[176:179], v[32:35]
    ds_read_b128 v[200:203], v22 offset:0
    v_mfma_f32_16x16x32_bf16 v[36:39], v[228:231], v[180:183], v[36:39]
    s_waitcnt lgkmcnt(6)
    v_mfma_f32_16x16x32_bf16 v[40:43], v[232:235], v[168:171], v[40:43]
    v_mfma_f32_16x16x32_bf16 v[44:47], v[232:235], v[172:175], v[44:47]
    v_mfma_f32_16x16x32_bf16 v[40:43], v[232:235], v[176:179], v[40:43]
    ds_read_b128 v[204:207], v22 offset:2048
    v_mfma_f32_16x16x32_bf16 v[44:47], v[232:235], v[180:183], v[44:47]
    s_waitcnt lgkmcnt(6)
    v_mfma_f32_16x16x32_bf16 v[48:51], v[236:239], v[168:171], v[48:51]
    v_mfma_f32_16x16x32_bf16 v[52:55], v[236:239], v[172:175], v[52:55]
    v_mfma_f32_16x16x32_bf16 v[48:51], v[236:239], v[176:179], v[48:51]
    ds_read_b128 v[208:211], v22 offset:4096
    v_mfma_f32_16x16x32_bf16 v[52:55], v[236:239], v[180:183], v[52:55]
    s_waitcnt lgkmcnt(6)
    v_mfma_f32_16x16x32_bf16 v[56:59], v[240:243], v[168:171], v[56:59]
    v_mfma_f32_16x16x32_bf16 v[60:63], v[240:243], v[172:175], v[60:63]
    v_mfma_f32_16x16x32_bf16 v[56:59], v[240:243], v[176:179], v[56:59]
    ds_read_b128 v[212:215], v22 offset:6144
    v_mfma_f32_16x16x32_bf16 v[60:63], v[240:243], v[180:183], v[60:63]
    s_waitcnt lgkmcnt(6)
    v_mfma_f32_16x16x32_bf16 v[64:67], v[244:247], v[168:171], v[64:67]
    v_mfma_f32_16x16x32_bf16 v[68:71], v[244:247], v[172:175], v[68:71]
    v_mfma_f32_16x16x32_bf16 v[64:67], v[244:247], v[176:179], v[64:67]
    ds_read_b128 v[216:219], v22 offset:8192
    v_mfma_f32_16x16x32_bf16 v[68:71], v[244:247], v[180:183], v[68:71]
    s_waitcnt lgkmcnt(6)
    v_mfma_f32_16x16x32_bf16 v[72:75], v[248:251], v[168:171], v[72:75]
    v_mfma_f32_16x16x32_bf16 v[76:79], v[248:251], v[172:175], v[76:79]
    v_mfma_f32_16x16x32_bf16 v[72:75], v[248:251], v[176:179], v[72:75]
    ds_read_b128 v[220:223], v22 offset:10240
    v_mfma_f32_16x16x32_bf16 v[76:79], v[248:251], v[180:183], v[76:79]
    s_waitcnt lgkmcnt(6)
    v_mfma_f32_16x16x32_bf16 v[80:83], v[252:255], v[168:171], v[80:83]
    v_mfma_f32_16x16x32_bf16 v[84:87], v[252:255], v[172:175], v[84:87]
    v_mfma_f32_16x16x32_bf16 v[80:83], v[252:255], v[176:179], v[80:83]
    ds_read_b128 v[224:227], v22 offset:12288
    v_mfma_f32_16x16x32_bf16 v[84:87], v[252:255], v[180:183], v[84:87]
    s_waitcnt vmcnt(0)
    s_waitcnt lgkmcnt(6)
    v_mfma_f32_16x16x32_bf16 v[32:35], v[200:203], v[184:187], v[32:35]
    v_mfma_f32_16x16x32_bf16 v[36:39], v[200:203], v[188:191], v[36:39]
    v_mfma_f32_16x16x32_bf16 v[32:35], v[200:203], v[192:195], v[32:35]
    v_mfma_f32_16x16x32_bf16 v[36:39], v[200:203], v[196:199], v[36:39]
    s_waitcnt lgkmcnt(5)
    v_mfma_f32_16x16x32_bf16 v[40:43], v[204:207], v[184:187], v[40:43]
    v_mfma_f32_16x16x32_bf16 v[44:47], v[204:207], v[188:191], v[44:47]
    v_mfma_f32_16x16x32_bf16 v[40:43], v[204:207], v[192:195], v[40:43]
    v_mfma_f32_16x16x32_bf16 v[44:47], v[204:207], v[196:199], v[44:47]
    s_waitcnt lgkmcnt(4)
    v_mfma_f32_16x16x32_bf16 v[48:51], v[208:211], v[184:187], v[48:51]
    v_mfma_f32_16x16x32_bf16 v[52:55], v[208:211], v[188:191], v[52:55]
    v_mfma_f32_16x16x32_bf16 v[48:51], v[208:211], v[192:195], v[48:51]
    v_mfma_f32_16x16x32_bf16 v[52:55], v[208:211], v[196:199], v[52:55]
    s_waitcnt lgkmcnt(3)
    v_mfma_f32_16x16x32_bf16 v[56:59], v[212:215], v[184:187], v[56:59]
    v_mfma_f32_16x16x32_bf16 v[60:63], v[212:215], v[188:191], v[60:63]
    v_mfma_f32_16x16x32_bf16 v[56:59], v[212:215], v[192:195], v[56:59]
    v_mfma_f32_16x16x32_bf16 v[60:63], v[212:215], v[196:199], v[60:63]
    s_waitcnt lgkmcnt(2)
    v_mfma_f32_16x16x32_bf16 v[64:67], v[216:219], v[184:187], v[64:67]
    v_mfma_f32_16x16x32_bf16 v[68:71], v[216:219], v[188:191], v[68:71]
    v_mfma_f32_16x16x32_bf16 v[64:67], v[216:219], v[192:195], v[64:67]
    v_mfma_f32_16x16x32_bf16 v[68:71], v[216:219], v[196:199], v[68:71]
    s_waitcnt lgkmcnt(1)
    v_mfma_f32_16x16x32_bf16 v[72:75], v[220:223], v[184:187], v[72:75]
    v_mfma_f32_16x16x32_bf16 v[76:79], v[220:223], v[188:191], v[76:79]
    v_mfma_f32_16x16x32_bf16 v[72:75], v[220:223], v[192:195], v[72:75]
    v_mfma_f32_16x16x32_bf16 v[76:79], v[220:223], v[196:199], v[76:79]
    s_waitcnt lgkmcnt(0)
    v_mfma_f32_16x16x32_bf16 v[80:83], v[224:227], v[184:187], v[80:83]
    v_mfma_f32_16x16x32_bf16 v[84:87], v[224:227], v[188:191], v[84:87]
    v_mfma_f32_16x16x32_bf16 v[80:83], v[224:227], v[192:195], v[80:83]
    v_mfma_f32_16x16x32_bf16 v[84:87], v[224:227], v[196:199], v[84:87]
    s_mul_i32 s48, s17, 14336
    s_add_u32 s48, s48, 81920
    v_add_u32 v4, s48, v2
    v_and_b32 v5, 15, v0
    v_mul_u32_u24 v5, 896, v5
    v_lshl_add_u32 v7, v3, 4, v5
    v_lshl_add_u32 v8, v3, 3, v5
    s_lshl_b32 s48, s14, 1
    s_add_u32 s48, s48, s16
    s_mul_i32 s48, s48, 28672
    s_mul_i32 s49, s15, 224
    s_add_u32 s48, s48, s49
    s_lshl_b32 s24, s17, 1
    s_sub_u32 s25, s24, 3
    s_cmp_ge_u32 s24, 3
    s_cselect_b32 s24, s25, s24
    s_cselect_b32 s25, 1, 0
    s_lshl_b32 s26, s24, 12
    s_lshl_b32 s27, s25, 10
    s_add_u32 s26, s26, s27
    s_add_u32 s26, s26, 81920
    v_add_u32 v10, s26, v2
    s_mul_i32 s25, s25, 14336
    s_lshl_b32 s24, s24, 6
    s_add_u32 s24, s24, s25
    s_add_u32 s91, s24, s48
    s_lshl_b32 s24, s17, 1
    s_add_u32 s24, s24, 1
    s_sub_u32 s25, s24, 3
    s_cmp_ge_u32 s24, 3
    s_cselect_b32 s24, s25, s24
    s_cselect_b32 s25, 1, 0
    s_lshl_b32 s26, s24, 12
    s_lshl_b32 s27, s25, 10
    s_add_u32 s26, s26, s27
    s_add_u32 s26, s26, 81920
    v_add_u32 v11, s26, v2
    s_mul_i32 s25, s25, 14336
    s_lshl_b32 s24, s24, 6
    s_add_u32 s24, s24, s25
    s_add_u32 s92, s24, s48
    s_barrier
    ds_write_b128 v4, v[32:35] offset:0
    ds_write_b128 v4, v[36:39] offset:1024
    ds_write_b128 v4, v[40:43] offset:2048
    ds_write_b128 v4, v[44:47] offset:3072
    ds_write_b128 v4, v[48:51] offset:4096
    ds_write_b128 v4, v[52:55] offset:5120
    ds_write_b128 v4, v[56:59] offset:6144
    ds_write_b128 v4, v[60:63] offset:7168
    ds_write_b128 v4, v[64:67] offset:8192
    ds_write_b128 v4, v[68:71] offset:9216
    ds_write_b128 v4, v[72:75] offset:10240
    ds_write_b128 v4, v[76:79] offset:11264
    ds_write_b128 v4, v[80:83] offset:12288
    ds_write_b128 v4, v[84:87] offset:13312
    s_waitcnt lgkmcnt(0)
    s_barrier
    s_cmp_eq_u32 s17, 3
    s_cbranch_scc1 L_fin3
    ds_read_b128 v[88:91], v10 offset:0
    ds_read_b128 v[92:95], v10 offset:14336
    ds_read_b128 v[96:99], v10 offset:28672
    ds_read_b128 v[100:103], v10 offset:43008
    ds_read_b128 v[104:107], v10 offset:2048
    ds_read_b128 v[108:111], v10 offset:16384
    ds_read_b128 v[112:115], v10 offset:30720
    ds_read_b128 v[116:119], v10 offset:45056
    ds_read_b128 v[120:123], v11 offset:0
    ds_read_b128 v[124:127], v11 offset:14336
    ds_read_b128 v[128:131], v11 offset:28672
    ds_read_b128 v[132:135], v11 offset:43008
    ds_read_b128 v[136:139], v11 offset:2048
    ds_read_b128 v[140:143], v11 offset:16384
    ds_read_b128 v[144:147], v11 offset:30720
    ds_read_b128 v[148:151], v11 offset:45056
    s_waitcnt lgkmcnt(8)
    v_add_f32 v88, v88, v92
    v_add_f32 v96, v96, v100
    v_add_f32 v89, v89, v93
    v_add_f32 v97, v97, v101
    v_add_f32 v90, v90, v94
    v_add_f32 v98, v98, v102
    v_add_f32 v91, v91, v95
    v_add_f32 v99, v99, v103
    v_add_f32 v88, v88, v96
    v_add_f32 v89, v89, v97
    v_add_f32 v90, v90, v98
    v_add_f32 v91, v91, v99
    v_cvt_pk_bf16_f32 v160, v88, v89
    v_cvt_pk_bf16_f32 v161, v90, v91
    v_add_f32 v104, v104, v108
    v_add_f32 v112, v112, v116
    v_add_f32 v105, v105, v109
    v_add_f32 v113, v113, v117
    v_add_f32 v106, v106, v110
    v_add_f32 v114, v114, v118
    v_add_f32 v107, v107, v111
    v_add_f32 v115, v115, v119
    v_add_f32 v104, v104, v112
    v_add_f32 v105, v105, v113
    v_add_f32 v106, v106, v114
    v_add_f32 v107, v107, v115
    v_cvt_pk_bf16_f32 v162, v104, v105
    v_cvt_pk_bf16_f32 v163, v106, v107
    buffer_store_dwordx4 v[160:163], v7, s[20:23], s91 offen
    s_waitcnt lgkmcnt(0)
    v_add_f32 v120, v120, v124
    v_add_f32 v128, v128, v132
    v_add_f32 v121, v121, v125
    v_add_f32 v129, v129, v133
    v_add_f32 v122, v122, v126
    v_add_f32 v130, v130, v134
    v_add_f32 v123, v123, v127
    v_add_f32 v131, v131, v135
    v_add_f32 v120, v120, v128
    v_add_f32 v121, v121, v129
    v_add_f32 v122, v122, v130
    v_add_f32 v123, v123, v131
    v_cvt_pk_bf16_f32 v164, v120, v121
    v_cvt_pk_bf16_f32 v165, v122, v123
    v_add_f32 v136, v136, v140
    v_add_f32 v144, v144, v148
    v_add_f32 v137, v137, v141
    v_add_f32 v145, v145, v149
    v_add_f32 v138, v138, v142
    v_add_f32 v146, v146, v150
    v_add_f32 v139, v139, v143
    v_add_f32 v147, v147, v151
    v_add_f32 v136, v136, v144
    v_add_f32 v137, v137, v145
    v_add_f32 v138, v138, v146
    v_add_f32 v139, v139, v147
    v_cvt_pk_bf16_f32 v166, v136, v137
    v_cvt_pk_bf16_f32 v167, v138, v139
    buffer_store_dwordx4 v[164:167], v7, s[20:23], s92 offen
    s_branch L_end
L_fin3:
    v_add_u32 v10, 94208, v2
    s_add_u32 s49, s48, 14336
    ds_read_b128 v[88:91], v10 offset:0
    ds_read_b128 v[92:95], v10 offset:14336
    ds_read_b128 v[96:99], v10 offset:28672
    ds_read_b128 v[100:103], v10 offset:43008
    ds_read_b128 v[104:107], v10 offset:1024
    ds_read_b128 v[108:111], v10 offset:15360
    ds_read_b128 v[112:115], v10 offset:29696
    ds_read_b128 v[116:119], v10 offset:44032
    s_waitcnt lgkmcnt(0)
    v_add_f32 v88, v88, v92
    v_add_f32 v96, v96, v100
    v_add_f32 v89, v89, v93
    v_add_f32 v97, v97, v101
    v_add_f32 v90, v90, v94
    v_add_f32 v98, v98, v102
    v_add_f32 v91, v91, v95
    v_add_f32 v99, v99, v103
    v_add_f32 v88, v88, v96
    v_add_f32 v89, v89, v97
    v_add_f32 v90, v90, v98
    v_add_f32 v91, v91, v99
    v_cvt_pk_bf16_f32 v160, v88, v89
    v_cvt_pk_bf16_f32 v161, v90, v91
    buffer_store_dwordx2 v[160:161], v8, s[20:23], s48 offen offset:192
    v_add_f32 v104, v104, v108
    v_add_f32 v112, v112, v116
    v_add_f32 v105, v105, v109
    v_add_f32 v113, v113, v117
    v_add_f32 v106, v106, v110
    v_add_f32 v114, v114, v118
    v_add_f32 v107, v107, v111
    v_add_f32 v115, v115, v119
    v_add_f32 v104, v104, v112
    v_add_f32 v105, v105, v113
    v_add_f32 v106, v106, v114
    v_add_f32 v107, v107, v115
    v_cvt_pk_bf16_f32 v162, v104, v105
    v_cvt_pk_bf16_f32 v163, v106, v107
    buffer_store_dwordx2 v[162:163], v8, s[20:23], s49 offen offset:192
L_end:
L_done:
    s_endpgm
L_clrslow:
    s_sleep 8
    buffer_load_dword v14, v12, s[48:51], s3 offen sc1
    s_add_u32 s28, s28, 1
    s_waitcnt vmcnt(0)
    v_readfirstlane_b32 s30, v14
    s_cmp_eq_u32 s30, 1
    s_cbranch_scc1 L_clrok
    s_cmp_lt_u32 s28, 0x400000
    s_cbranch_scc1 L_clrslow
    s_branch L_clrok
L_codeend:
.section .rodata,"a"
.p2align 6
.amdhsa_kernel standalone__spectral_fnet__prompt_kernel
  .amdhsa_next_free_vgpr 256
  .amdhsa_next_free_sgpr 102
  .amdhsa_accum_offset 256
  .amdhsa_group_segment_fixed_size 0
  .amdhsa_kernarg_size 64
  .amdhsa_user_sgpr_count 2
  .amdhsa_user_sgpr_kernarg_segment_ptr 1
  .amdhsa_system_sgpr_workgroup_id_x 1
.end_amdhsa_kernel
```
